```python
import torch

def _softmax(x, axis=-1):
    return torch.softmax(x, dim=axis)
def _gelu(x):
    return torch.nn.functional.gelu(x, approximate="tanh")
def _silu(x):
    return torch.nn.functional.silu(x)
def _sigmoid(x):
    return torch.sigmoid(x)
def _layernorm(x, axis=-1, eps=1e-5):
    m = x.mean(dim=axis, keepdim=True)
    v = x.var(dim=axis, keepdim=True, unbiased=False)
    return (x - m) / torch.sqrt(v + eps)
def _scatter_add(tgt, idx, src, axis=0):
    return tgt.clone().index_add_(axis, idx, src)
def _segment_sum(src, seg, n):
    out = torch.zeros((n,) + src.shape[1:], dtype=src.dtype)
    return out.index_add_(0, seg, src)
def _pad(x, pw):
    flat = tuple(v for pair in reversed(pw) for v in pair)
    return torch.nn.functional.pad(x, flat)

kernel_name = 'standalone__rmsnorm__sampling'

def setup_inputs():

    _w = (lambda a: (lambda t: t.to(torch.bfloat16) if t.is_floating_point() else t)(torch.as_tensor(a)))
    B, S, D = 1024, 16, 576
    return {
        "x": _w((lambda *s: torch.randn(*s, dtype=torch.bfloat16) * 0.05)(B, S, D)),
        "g": _w((lambda *s: torch.randn(*s, dtype=torch.bfloat16) * 0.05)(D) + 1.0),
    }

def reference(x, g):
    rms = torch.sqrt((x * x).mean(axis=-1, keepdims=True) + 1e-6)
    return x / rms * g
```

```asm
; @launch grid=(512,1,1) block=(256,1,1) lds=0
.amdgcn_target "amdgcn-amd-amdhsa--gfx950"
.text
.globl standalone__rmsnorm__sampling_kernel
.p2align 12
.p2align 8
.type standalone__rmsnorm__sampling_kernel,@function
standalone__rmsnorm__sampling_kernel:
    s_load_dwordx4 s[4:7], s[0:1], 0
    s_load_dwordx2 s[12:13], s[0:1], 16
    s_setprio 3
    s_cmpk_ge_u32 s2, 512
    s_cbranch_scc1 L_end
    v_lshl_add_u32 v2, s2, 8, v0
    v_lshrrev_b32 v3, 6, v2
    v_lshlrev_b32 v3, 13, v3
    v_lshl_add_u32 v1, v2, 4, v3
    v_add_u32 v1, 4032, v1
    v_mul_u32_u24 v2, 144, v2
    v_and_b32 v3, 7, v0
    v_and_b32 v0, 63, v0
    v_lshlrev_b32 v149, 7, v3
    v_sub_u32 v2, v2, v149
    v_lshlrev_b32 v0, 4, v0
    v_lshlrev_b32 v3, 4, v3
    s_branch L_pad1
L_back1:
    s_waitcnt lgkmcnt(0)
    global_load_dwordx4 v[40:43], v0, s[6:7]
    global_load_dwordx4 v[44:47], v3, s[6:7] offset:1024
    global_load_dwordx4 v[4:7], v1, s[4:5] offset:-4032 nt
    global_load_dwordx4 v[8:11], v1, s[4:5] offset:-2880 nt
    global_load_dwordx4 v[12:15], v1, s[4:5] offset:-1728 nt
    global_load_dwordx4 v[16:19], v1, s[4:5] offset:-576 nt
    global_load_dwordx4 v[20:23], v1, s[4:5] offset:576 nt
    global_load_dwordx4 v[24:27], v1, s[4:5] offset:1728 nt
    global_load_dwordx4 v[28:31], v1, s[4:5] offset:2880 nt
    global_load_dwordx4 v[32:35], v1, s[4:5] offset:4032 nt
    global_load_dwordx4 v[36:39], v2, s[4:5] offset:1024 nt
    s_setprio 0
    s_branch L_pad2
L_back2:
    s_cmp_eq_u32 s2, s2
    s_mov_b32 s16, 0xffff0000
    s_mov_b32 s17, 0x3f803f80
    v_mov_b32 v136, 0
    v_mov_b32 v137, 0
    v_mov_b32 v138, 0
    v_mov_b32 v139, 0
    v_mov_b32 v140, 0
    v_mov_b32 v141, 0
    v_mov_b32 v142, 0
    v_mov_b32 v143, 0
    v_mov_b32 v144, 0
    s_waitcnt vmcnt(9)
    v_lshlrev_b32 v48, 16, v40
    v_and_b32 v49, s16, v40
    v_lshlrev_b32 v50, 16, v41
    v_and_b32 v51, s16, v41
    v_lshlrev_b32 v52, 16, v42
    v_and_b32 v53, s16, v42
    v_lshlrev_b32 v54, 16, v43
    v_and_b32 v55, s16, v43
    v_lshlrev_b32 v56, 16, v44
    v_and_b32 v57, s16, v44
    v_lshlrev_b32 v58, 16, v45
    v_and_b32 v59, s16, v45
    v_lshlrev_b32 v60, 16, v46
    v_and_b32 v61, s16, v46
    v_lshlrev_b32 v62, 16, v47
    v_and_b32 v63, s16, v47
    s_waitcnt vmcnt(8)
    v_lshlrev_b32 v64, 16, v4
    v_and_b32 v65, s16, v4
    v_lshlrev_b32 v66, 16, v5
    v_and_b32 v67, s16, v5
    v_lshlrev_b32 v68, 16, v6
    v_and_b32 v69, s16, v6
    v_lshlrev_b32 v70, 16, v7
    v_and_b32 v71, s16, v7
    v_pk_mul_f32 v[146:147], v[64:65], v[64:65]
    v_pk_mul_f32 v[148:149], v[66:67], v[66:67]
    v_pk_mul_f32 v[150:151], v[68:69], v[68:69]
    v_pk_mul_f32 v[152:153], v[70:71], v[70:71]
    v_cvt_pk_bf16_f32 v146, v146, v147
    v_cvt_pk_bf16_f32 v148, v148, v149
    v_cvt_pk_bf16_f32 v150, v150, v151
    v_cvt_pk_bf16_f32 v152, v152, v153
    v_dot2c_f32_bf16 v136, s17, v146
    v_dot2c_f32_bf16 v136, s17, v148
    v_dot2c_f32_bf16 v136, s17, v150
    v_dot2c_f32_bf16 v136, s17, v152
    v_pk_mul_f32 v[64:65], v[64:65], v[48:49]
    v_pk_mul_f32 v[66:67], v[66:67], v[50:51]
    v_pk_mul_f32 v[68:69], v[68:69], v[52:53]
    v_pk_mul_f32 v[70:71], v[70:71], v[54:55]
    s_waitcnt vmcnt(7)
    v_lshlrev_b32 v72, 16, v8
    v_and_b32 v73, s16, v8
    v_lshlrev_b32 v74, 16, v9
    v_and_b32 v75, s16, v9
    v_lshlrev_b32 v76, 16, v10
    v_and_b32 v77, s16, v10
    v_lshlrev_b32 v78, 16, v11
    v_and_b32 v79, s16, v11
    v_pk_mul_f32 v[146:147], v[72:73], v[72:73]
    v_pk_mul_f32 v[148:149], v[74:75], v[74:75]
    v_pk_mul_f32 v[150:151], v[76:77], v[76:77]
    v_pk_mul_f32 v[152:153], v[78:79], v[78:79]
    v_cvt_pk_bf16_f32 v146, v146, v147
    v_cvt_pk_bf16_f32 v148, v148, v149
    v_cvt_pk_bf16_f32 v150, v150, v151
    v_cvt_pk_bf16_f32 v152, v152, v153
    v_dot2c_f32_bf16 v137, s17, v146
    v_dot2c_f32_bf16 v137, s17, v148
    v_dot2c_f32_bf16 v137, s17, v150
    v_dot2c_f32_bf16 v137, s17, v152
    v_pk_mul_f32 v[72:73], v[72:73], v[48:49]
    v_pk_mul_f32 v[74:75], v[74:75], v[50:51]
    v_pk_mul_f32 v[76:77], v[76:77], v[52:53]
    v_pk_mul_f32 v[78:79], v[78:79], v[54:55]
    s_waitcnt vmcnt(6)
    v_lshlrev_b32 v80, 16, v12
    v_and_b32 v81, s16, v12
    v_lshlrev_b32 v82, 16, v13
    v_and_b32 v83, s16, v13
    v_lshlrev_b32 v84, 16, v14
    v_and_b32 v85, s16, v14
    v_lshlrev_b32 v86, 16, v15
    v_and_b32 v87, s16, v15
    v_pk_mul_f32 v[146:147], v[80:81], v[80:81]
    v_pk_mul_f32 v[148:149], v[82:83], v[82:83]
    v_pk_mul_f32 v[150:151], v[84:85], v[84:85]
    v_pk_mul_f32 v[152:153], v[86:87], v[86:87]
    v_cvt_pk_bf16_f32 v146, v146, v147
    v_cvt_pk_bf16_f32 v148, v148, v149
    v_cvt_pk_bf16_f32 v150, v150, v151
    v_cvt_pk_bf16_f32 v152, v152, v153
    v_dot2c_f32_bf16 v138, s17, v146
    v_dot2c_f32_bf16 v138, s17, v148
    v_dot2c_f32_bf16 v138, s17, v150
    v_dot2c_f32_bf16 v138, s17, v152
    v_pk_mul_f32 v[80:81], v[80:81], v[48:49]
    v_pk_mul_f32 v[82:83], v[82:83], v[50:51]
    v_pk_mul_f32 v[84:85], v[84:85], v[52:53]
    v_pk_mul_f32 v[86:87], v[86:87], v[54:55]
    s_waitcnt vmcnt(5)
    v_lshlrev_b32 v88, 16, v16
    v_and_b32 v89, s16, v16
    v_lshlrev_b32 v90, 16, v17
    v_and_b32 v91, s16, v17
    v_lshlrev_b32 v92, 16, v18
    v_and_b32 v93, s16, v18
    v_lshlrev_b32 v94, 16, v19
    v_and_b32 v95, s16, v19
    v_pk_mul_f32 v[146:147], v[88:89], v[88:89]
    v_pk_mul_f32 v[148:149], v[90:91], v[90:91]
    v_pk_mul_f32 v[150:151], v[92:93], v[92:93]
    v_pk_mul_f32 v[152:153], v[94:95], v[94:95]
    v_cvt_pk_bf16_f32 v146, v146, v147
    v_cvt_pk_bf16_f32 v148, v148, v149
    v_cvt_pk_bf16_f32 v150, v150, v151
    v_cvt_pk_bf16_f32 v152, v152, v153
    v_dot2c_f32_bf16 v139, s17, v146
    v_dot2c_f32_bf16 v139, s17, v148
    v_dot2c_f32_bf16 v139, s17, v150
    v_dot2c_f32_bf16 v139, s17, v152
    v_pk_mul_f32 v[88:89], v[88:89], v[48:49]
    v_pk_mul_f32 v[90:91], v[90:91], v[50:51]
    v_pk_mul_f32 v[92:93], v[92:93], v[52:53]
    v_pk_mul_f32 v[94:95], v[94:95], v[54:55]
    s_waitcnt vmcnt(4)
    v_lshlrev_b32 v96, 16, v20
    v_and_b32 v97, s16, v20
    v_lshlrev_b32 v98, 16, v21
    v_and_b32 v99, s16, v21
    v_lshlrev_b32 v100, 16, v22
    v_and_b32 v101, s16, v22
    v_lshlrev_b32 v102, 16, v23
    v_and_b32 v103, s16, v23
    v_pk_mul_f32 v[146:147], v[96:97], v[96:97]
    v_pk_mul_f32 v[148:149], v[98:99], v[98:99]
    v_pk_mul_f32 v[150:151], v[100:101], v[100:101]
    v_pk_mul_f32 v[152:153], v[102:103], v[102:103]
    v_cvt_pk_bf16_f32 v146, v146, v147
    v_cvt_pk_bf16_f32 v148, v148, v149
    v_cvt_pk_bf16_f32 v150, v150, v151
    v_cvt_pk_bf16_f32 v152, v152, v153
    v_dot2c_f32_bf16 v140, s17, v146
    v_dot2c_f32_bf16 v140, s17, v148
    v_dot2c_f32_bf16 v140, s17, v150
L_pad1:
    s_cbranch_scc0 L_back1
    v_dot2c_f32_bf16 v140, s17, v152
    v_pk_mul_f32 v[96:97], v[96:97], v[48:49]
    v_pk_mul_f32 v[98:99], v[98:99], v[50:51]
    v_pk_mul_f32 v[100:101], v[100:101], v[52:53]
    v_pk_mul_f32 v[102:103], v[102:103], v[54:55]
    s_waitcnt vmcnt(3)
    v_lshlrev_b32 v104, 16, v24
    v_and_b32 v105, s16, v24
    v_lshlrev_b32 v106, 16, v25
    v_and_b32 v107, s16, v25
    v_lshlrev_b32 v108, 16, v26
    v_and_b32 v109, s16, v26
    v_lshlrev_b32 v110, 16, v27
    v_and_b32 v111, s16, v27
    v_pk_mul_f32 v[146:147], v[104:105], v[104:105]
    v_pk_mul_f32 v[148:149], v[106:107], v[106:107]
    v_pk_mul_f32 v[150:151], v[108:109], v[108:109]
    v_pk_mul_f32 v[152:153], v[110:111], v[110:111]
    v_cvt_pk_bf16_f32 v146, v146, v147
    v_cvt_pk_bf16_f32 v148, v148, v149
    v_cvt_pk_bf16_f32 v150, v150, v151
    v_cvt_pk_bf16_f32 v152, v152, v153
    v_dot2c_f32_bf16 v141, s17, v146
    v_dot2c_f32_bf16 v141, s17, v148
    v_dot2c_f32_bf16 v141, s17, v150
    v_dot2c_f32_bf16 v141, s17, v152
    v_pk_mul_f32 v[104:105], v[104:105], v[48:49]
    v_pk_mul_f32 v[106:107], v[106:107], v[50:51]
    v_pk_mul_f32 v[108:109], v[108:109], v[52:53]
    v_pk_mul_f32 v[110:111], v[110:111], v[54:55]
    s_waitcnt vmcnt(2)
    v_lshlrev_b32 v112, 16, v28
    v_and_b32 v113, s16, v28
    v_lshlrev_b32 v114, 16, v29
    v_and_b32 v115, s16, v29
    v_lshlrev_b32 v116, 16, v30
    v_and_b32 v117, s16, v30
    v_lshlrev_b32 v118, 16, v31
    v_and_b32 v119, s16, v31
    v_pk_mul_f32 v[146:147], v[112:113], v[112:113]
    v_pk_mul_f32 v[148:149], v[114:115], v[114:115]
    v_pk_mul_f32 v[150:151], v[116:117], v[116:117]
    v_pk_mul_f32 v[152:153], v[118:119], v[118:119]
    v_cvt_pk_bf16_f32 v146, v146, v147
    v_cvt_pk_bf16_f32 v148, v148, v149
    v_cvt_pk_bf16_f32 v150, v150, v151
    v_cvt_pk_bf16_f32 v152, v152, v153
    v_dot2c_f32_bf16 v142, s17, v146
    v_dot2c_f32_bf16 v142, s17, v148
    v_dot2c_f32_bf16 v142, s17, v150
    v_dot2c_f32_bf16 v142, s17, v152
    v_pk_mul_f32 v[112:113], v[112:113], v[48:49]
    v_pk_mul_f32 v[114:115], v[114:115], v[50:51]
    v_pk_mul_f32 v[116:117], v[116:117], v[52:53]
    v_pk_mul_f32 v[118:119], v[118:119], v[54:55]
    s_waitcnt vmcnt(1)
    v_lshlrev_b32 v120, 16, v32
    v_and_b32 v121, s16, v32
    v_lshlrev_b32 v122, 16, v33
    v_and_b32 v123, s16, v33
    v_lshlrev_b32 v124, 16, v34
    v_and_b32 v125, s16, v34
    v_lshlrev_b32 v126, 16, v35
    v_and_b32 v127, s16, v35
    v_pk_mul_f32 v[146:147], v[120:121], v[120:121]
    v_pk_mul_f32 v[148:149], v[122:123], v[122:123]
    v_pk_mul_f32 v[150:151], v[124:125], v[124:125]
    v_pk_mul_f32 v[152:153], v[126:127], v[126:127]
    v_cvt_pk_bf16_f32 v146, v146, v147
    v_cvt_pk_bf16_f32 v148, v148, v149
    v_cvt_pk_bf16_f32 v150, v150, v151
    v_cvt_pk_bf16_f32 v152, v152, v153
    v_dot2c_f32_bf16 v143, s17, v146
    v_dot2c_f32_bf16 v143, s17, v148
    v_dot2c_f32_bf16 v143, s17, v150
    v_dot2c_f32_bf16 v143, s17, v152
    v_pk_mul_f32 v[120:121], v[120:121], v[48:49]
    v_pk_mul_f32 v[122:123], v[122:123], v[50:51]
    v_pk_mul_f32 v[124:125], v[124:125], v[52:53]
    v_pk_mul_f32 v[126:127], v[126:127], v[54:55]
    s_nop 2
    v_permlane32_swap_b32 v136, v140
    v_permlane32_swap_b32 v137, v141
    v_permlane32_swap_b32 v138, v142
    v_permlane32_swap_b32 v139, v143
    v_add_f32 v136, v136, v140
    v_add_f32 v137, v137, v141
    v_add_f32 v138, v138, v142
    v_add_f32 v139, v139, v143
    s_nop 0
    v_permlane16_swap_b32 v136, v138
    v_permlane16_swap_b32 v137, v139
    v_add_f32 v136, v136, v138
    v_add_f32 v137, v137, v139
    s_nop 1
    v_add_f32_dpp v138, v136, v136 row_ror:8 row_mask:0xf bank_mask:0x3
    v_add_f32_dpp v138, v137, v137 row_ror:8 row_mask:0xf bank_mask:0xc
    s_waitcnt vmcnt(0)
    v_lshlrev_b32 v128, 16, v36
    v_and_b32 v129, s16, v36
    v_lshlrev_b32 v130, 16, v37
L_pad2:
    s_cbranch_scc0 L_back2
    v_and_b32 v131, s16, v37
    v_lshlrev_b32 v132, 16, v38
    v_and_b32 v133, s16, v38
    v_lshlrev_b32 v134, 16, v39
    v_and_b32 v135, s16, v39
    v_pk_mul_f32 v[146:147], v[128:129], v[128:129]
    v_pk_mul_f32 v[148:149], v[130:131], v[130:131]
    v_pk_mul_f32 v[150:151], v[132:133], v[132:133]
    v_pk_mul_f32 v[152:153], v[134:135], v[134:135]
    v_cvt_pk_bf16_f32 v146, v146, v147
    v_cvt_pk_bf16_f32 v148, v148, v149
    v_cvt_pk_bf16_f32 v150, v150, v151
    v_cvt_pk_bf16_f32 v152, v152, v153
    v_dot2c_f32_bf16 v144, s17, v146
    v_dot2c_f32_bf16 v144, s17, v148
    v_dot2c_f32_bf16 v144, s17, v150
    v_dot2c_f32_bf16 v144, s17, v152
    v_pk_mul_f32 v[128:129], v[128:129], v[56:57]
    v_pk_mul_f32 v[130:131], v[130:131], v[58:59]
    v_pk_mul_f32 v[132:133], v[132:133], v[60:61]
    v_pk_mul_f32 v[134:135], v[134:135], v[62:63]
    s_nop 2
    v_add_f32 v138, v138, v144
    s_nop 1
    v_add_f32_dpp v138, v138, v138 quad_perm:[1,0,3,2] row_mask:0xf bank_mask:0xf
    s_nop 1
    v_add_f32_dpp v138, v138, v138 quad_perm:[2,3,0,1] row_mask:0xf bank_mask:0xf
    s_nop 1
    v_add_f32_dpp v138, v138, v138 row_half_mirror row_mask:0xf bank_mask:0xf
    v_mul_f32 v138, 0x3ae38e39, v138
    v_cvt_pk_bf16_f32 v138, v138, v138
    v_and_b32 v138, s16, v138
    v_add_f32 v138, 0x358637bd, v138
    v_cvt_pk_bf16_f32 v138, v138, v138
    v_and_b32 v138, s16, v138
    v_sqrt_f32 v138, v138
    s_nop 0
    v_cvt_pk_bf16_f32 v138, v138, v138
    v_and_b32 v138, s16, v138
    v_rcp_f32 v138, v138
    s_nop 1
    v_readlane_b32 s20, v138, 0
    v_readlane_b32 s22, v138, 8
    v_readlane_b32 s24, v138, 16
    v_readlane_b32 s26, v138, 24
    v_readlane_b32 s28, v138, 32
    v_readlane_b32 s30, v138, 40
    v_readlane_b32 s32, v138, 48
    v_readlane_b32 s34, v138, 56
    v_pk_mul_f32 v[128:129], v[128:129], v[138:139] op_sel_hi:[1,0]
    v_pk_mul_f32 v[130:131], v[130:131], v[138:139] op_sel_hi:[1,0]
    v_pk_mul_f32 v[132:133], v[132:133], v[138:139] op_sel_hi:[1,0]
    v_pk_mul_f32 v[134:135], v[134:135], v[138:139] op_sel_hi:[1,0]
    v_cvt_pk_bf16_f32 v36, v128, v129
    v_cvt_pk_bf16_f32 v37, v130, v131
    v_cvt_pk_bf16_f32 v38, v132, v133
    v_cvt_pk_bf16_f32 v39, v134, v135
    global_store_dwordx4 v2, v[36:39], s[12:13] offset:1024 nt
    v_pk_mul_f32 v[64:65], v[64:65], s[20:21] op_sel_hi:[1,0]
    v_pk_mul_f32 v[66:67], v[66:67], s[20:21] op_sel_hi:[1,0]
    v_pk_mul_f32 v[68:69], v[68:69], s[20:21] op_sel_hi:[1,0]
    v_pk_mul_f32 v[70:71], v[70:71], s[20:21] op_sel_hi:[1,0]
    v_cvt_pk_bf16_f32 v4, v64, v65
    v_cvt_pk_bf16_f32 v5, v66, v67
    v_cvt_pk_bf16_f32 v6, v68, v69
    v_cvt_pk_bf16_f32 v7, v70, v71
    global_store_dwordx4 v1, v[4:7], s[12:13] offset:-4032 nt
    v_pk_mul_f32 v[72:73], v[72:73], s[22:23] op_sel_hi:[1,0]
    v_pk_mul_f32 v[74:75], v[74:75], s[22:23] op_sel_hi:[1,0]
    v_pk_mul_f32 v[76:77], v[76:77], s[22:23] op_sel_hi:[1,0]
    v_pk_mul_f32 v[78:79], v[78:79], s[22:23] op_sel_hi:[1,0]
    v_cvt_pk_bf16_f32 v8, v72, v73
    v_cvt_pk_bf16_f32 v9, v74, v75
    v_cvt_pk_bf16_f32 v10, v76, v77
    v_cvt_pk_bf16_f32 v11, v78, v79
    global_store_dwordx4 v1, v[8:11], s[12:13] offset:-2880 nt
    v_pk_mul_f32 v[80:81], v[80:81], s[24:25] op_sel_hi:[1,0]
    v_pk_mul_f32 v[82:83], v[82:83], s[24:25] op_sel_hi:[1,0]
    v_pk_mul_f32 v[84:85], v[84:85], s[24:25] op_sel_hi:[1,0]
    v_pk_mul_f32 v[86:87], v[86:87], s[24:25] op_sel_hi:[1,0]
    v_cvt_pk_bf16_f32 v12, v80, v81
    v_cvt_pk_bf16_f32 v13, v82, v83
    v_cvt_pk_bf16_f32 v14, v84, v85
    v_cvt_pk_bf16_f32 v15, v86, v87
    global_store_dwordx4 v1, v[12:15], s[12:13] offset:-1728 nt
    v_pk_mul_f32 v[88:89], v[88:89], s[26:27] op_sel_hi:[1,0]
    v_pk_mul_f32 v[90:91], v[90:91], s[26:27] op_sel_hi:[1,0]
    v_pk_mul_f32 v[92:93], v[92:93], s[26:27] op_sel_hi:[1,0]
    v_pk_mul_f32 v[94:95], v[94:95], s[26:27] op_sel_hi:[1,0]
    v_cvt_pk_bf16_f32 v16, v88, v89
    v_cvt_pk_bf16_f32 v17, v90, v91
    v_cvt_pk_bf16_f32 v18, v92, v93
    v_cvt_pk_bf16_f32 v19, v94, v95
    global_store_dwordx4 v1, v[16:19], s[12:13] offset:-576 nt
    v_pk_mul_f32 v[96:97], v[96:97], s[28:29] op_sel_hi:[1,0]
    v_pk_mul_f32 v[98:99], v[98:99], s[28:29] op_sel_hi:[1,0]
    v_pk_mul_f32 v[100:101], v[100:101], s[28:29] op_sel_hi:[1,0]
    v_pk_mul_f32 v[102:103], v[102:103], s[28:29] op_sel_hi:[1,0]
    v_cvt_pk_bf16_f32 v20, v96, v97
    v_cvt_pk_bf16_f32 v21, v98, v99
    v_cvt_pk_bf16_f32 v22, v100, v101
    v_cvt_pk_bf16_f32 v23, v102, v103
    global_store_dwordx4 v1, v[20:23], s[12:13] offset:576 nt
    v_pk_mul_f32 v[104:105], v[104:105], s[30:31] op_sel_hi:[1,0]
    v_pk_mul_f32 v[106:107], v[106:107], s[30:31] op_sel_hi:[1,0]
    v_pk_mul_f32 v[108:109], v[108:109], s[30:31] op_sel_hi:[1,0]
    v_pk_mul_f32 v[110:111], v[110:111], s[30:31] op_sel_hi:[1,0]
    v_cvt_pk_bf16_f32 v24, v104, v105
    v_cvt_pk_bf16_f32 v25, v106, v107
    v_cvt_pk_bf16_f32 v26, v108, v109
    v_cvt_pk_bf16_f32 v27, v110, v111
    global_store_dwordx4 v1, v[24:27], s[12:13] offset:1728 nt
    v_pk_mul_f32 v[112:113], v[112:113], s[32:33] op_sel_hi:[1,0]
    v_pk_mul_f32 v[114:115], v[114:115], s[32:33] op_sel_hi:[1,0]
    v_pk_mul_f32 v[116:117], v[116:117], s[32:33] op_sel_hi:[1,0]
    v_pk_mul_f32 v[118:119], v[118:119], s[32:33] op_sel_hi:[1,0]
    v_cvt_pk_bf16_f32 v28, v112, v113
    v_cvt_pk_bf16_f32 v29, v114, v115
    v_cvt_pk_bf16_f32 v30, v116, v117
    v_cvt_pk_bf16_f32 v31, v118, v119
    global_store_dwordx4 v1, v[28:31], s[12:13] offset:2880 nt
    v_pk_mul_f32 v[120:121], v[120:121], s[34:35] op_sel_hi:[1,0]
    v_pk_mul_f32 v[122:123], v[122:123], s[34:35] op_sel_hi:[1,0]
    v_pk_mul_f32 v[124:125], v[124:125], s[34:35] op_sel_hi:[1,0]
    v_pk_mul_f32 v[126:127], v[126:127], s[34:35] op_sel_hi:[1,0]
    v_cvt_pk_bf16_f32 v32, v120, v121
    v_cvt_pk_bf16_f32 v33, v122, v123
    v_cvt_pk_bf16_f32 v34, v124, v125
    v_cvt_pk_bf16_f32 v35, v126, v127
    global_store_dwordx4 v1, v[32:35], s[12:13] offset:4032 nt
L_end:
    s_endpgm
L_code_end:
.section .rodata,"a"
.p2align 6
.amdhsa_kernel standalone__rmsnorm__sampling_kernel
  .amdhsa_next_free_vgpr 154
  .amdhsa_next_free_sgpr 40
  .amdhsa_accum_offset 156
  .amdhsa_group_segment_fixed_size 0
  .amdhsa_kernarg_size 40
  .amdhsa_user_sgpr_count 2
  .amdhsa_user_sgpr_kernarg_segment_ptr 1
  .amdhsa_system_sgpr_workgroup_id_x 1
  .amdhsa_float_denorm_mode_32 3
  .amdhsa_float_denorm_mode_16_64 3
.end_amdhsa_kernel
```
